```python
import torch

def _softmax(x, axis=-1):
    return torch.softmax(x, dim=axis)
def _gelu(x):
    return torch.nn.functional.gelu(x, approximate="tanh")
def _silu(x):
    return torch.nn.functional.silu(x)
def _sigmoid(x):
    return torch.sigmoid(x)
def _layernorm(x, axis=-1, eps=1e-5):
    m = x.mean(dim=axis, keepdim=True)
    v = x.var(dim=axis, keepdim=True, unbiased=False)
    return (x - m) / torch.sqrt(v + eps)
def _scatter_add(tgt, idx, src, axis=0):
    return tgt.clone().index_add_(axis, idx, src)
def _segment_sum(src, seg, n):
    out = torch.zeros((n,) + src.shape[1:], dtype=src.dtype)
    return out.index_add_(0, seg, src)
def _pad(x, pw):
    flat = tuple(v for pair in reversed(pw) for v in pair)
    return torch.nn.functional.pad(x, flat)

kernel_name = 'standalone__softmax_full_bidir__decode'

def setup_inputs():

    _w = (lambda a: (lambda t: t.to(torch.bfloat16) if t.is_floating_point() else t)(torch.as_tensor(a)))
    B, H, Sq, Skv, Dh = 4, 32, 1, 16384, 128
    return {
        "q": _w((lambda *s: torch.randn(*s, dtype=torch.bfloat16) * 0.8)(B, H, Sq, Dh)),
        "k": _w((lambda *s: torch.randn(*s, dtype=torch.bfloat16) * 0.8)(B, H, Skv, Dh)),
        "v": _w((lambda *s: torch.randn(*s, dtype=torch.bfloat16) * 0.05)(B, H, Skv, Dh)),
    }

def reference(q, k, v):
    scale = q.shape[-1] ** -0.5
    scores = torch.einsum('bhqd,bhkd->bhqk', q, k) * scale
    attn = _softmax(scores, axis=-1)
    return torch.einsum('bhqk,bhkd->bhqd', attn, v)
```

```asm
; @launch grid=(256,1,1) block=(320,1,1) lds=71040
.amdgcn_target "amdgcn-amd-amdhsa--gfx950"
.text
.globl standalone__softmax_full_bidir__decode_kernel
.p2align 8
.type standalone__softmax_full_bidir__decode_kernel,@function
standalone__softmax_full_bidir__decode_kernel:
    s_cmp_ge_u32 s2, 256
    s_cbranch_scc1 L_end
    s_load_dwordx4 s[4:7], s[0:1], 0
    s_load_dwordx4 s[8:11], s[0:1], 16
    s_load_dwordx4 s[12:15], s[0:1], 32
    v_readfirstlane_b32 s30, v0
    v_and_b32 v3, 63, v0
    v_and_b32 v50, 3, v3
    v_lshlrev_b32 v50, 4, v50
    v_lshrrev_b32 v47, 4, v3
    v_lshl_add_u32 v50, v47, 6, v50
    v_bfe_u32 v1, v3, 2, 1
    v_lshlrev_b32 v1, 8, v1
    v_bfe_u32 v46, v3, 3, 1
    v_lshl_or_b32 v1, v46, 15, v1
    v_bfe_u32 v41, v0, 6, 1
    v_lshlrev_b32 v41, 11, v41
    v_bfe_u32 v46, v0, 7, 1
    v_lshl_or_b32 v41, v46, 12, v41
    v_add3_u32 v1, v1, v50, v41
    v_mov_b32 v55, v1
    v_mov_b32 v56, v1
    v_lshlrev_b32 v46, 4, v3
    s_lshr_b32 s30, s30, 6
    s_lshr_b32 s27, s2, 3
    s_lshr_b32 s63, s27, 3
    s_mov_b32 s51, 1024
    s_and_b32 s61, s2, 7
    s_mov_b32 s100, 8192
    s_mov_b32 s101, 73728
    s_xor_b32 s37, s61, s63
    s_bfe_u32 s24, s37, 65536
    s_lshl_b32 s24, s24, 19
    s_bfe_u32 s38, s37, 65537
    s_lshl_b32 s38, s38, 10
    s_or_b32 s24, s24, s38
    s_bfe_u32 s38, s37, 65538
    s_lshl_b32 s38, s38, 18
    s_or_b32 s24, s24, s38
    s_add_u32 s3, s24, 16384
    s_lshl_b32 s29, s27, 24
    s_lshl_b32 s28, s27, 10
    s_mov_b32 s18, 16777216
    s_mov_b32 s19, 0x20000
    s_mov_b32 s22, 16777216
    s_mov_b32 s23, 0x20000
    s_waitcnt lgkmcnt(0)
    s_add_u32 s6, s6, s29
    s_addc_u32 s7, s7, 0
    s_add_u32 s8, s8, s29
    s_addc_u32 s9, s9, 0
    s_add_u32 s68, s14, 2097152
    s_addc_u32 s69, s15, 0
    s_cmp_eq_u32 s30, 4
    s_cbranch_scc1 L_helper
    s_mov_b64 s[16:17], s[6:7]
    s_mov_b64 s[20:21], s[6:7]
    s_add_u32 s4, s4, s28
    s_addc_u32 s5, s5, 0
    global_load_dwordx4 v[24:27], v46, s[4:5]
    buffer_load_dwordx4 v[64:67], v55, s[16:19], s24 offen nt
    s_add_u32 s89, s24, 65536
    buffer_load_dwordx4 v[68:71], v55, s[16:19], s89 offen nt
    s_add_u32 s90, s24, s100
    buffer_load_dwordx4 v[72:75], v55, s[16:19], s90 offen nt
    s_add_u32 s91, s24, s101
    buffer_load_dwordx4 v[76:79], v55, s[16:19], s91 offen nt
    buffer_load_dwordx4 v[80:83], v56, s[20:23], s3 offen nt
    s_add_u32 s89, s3, 65536
    buffer_load_dwordx4 v[84:87], v56, s[20:23], s89 offen nt
    s_add_u32 s90, s3, s100
    buffer_load_dwordx4 v[88:91], v56, s[20:23], s90 offen nt
    s_add_u32 s91, s3, s101
    buffer_load_dwordx4 v[92:95], v56, s[20:23], s91 offen nt
    v_bfe_u32 v2, v3, 4, 1
    v_lshlrev_b32 v2, 8, v2
    v_bfe_u32 v40, v3, 5, 1
    v_lshl_or_b32 v2, v40, 15, v2
    v_and_b32 v40, 15, v3
    v_lshl_add_u32 v2, v40, 4, v2
    v_add_u32 v2, v2, v41
    s_mov_b32 s26, 0x3e0293ee
    s_mov_b32 s36, 0
    s_mov_b32 s32, 0
    s_mov_b32 s62, 64
    s_mov_b32 s49, 0
    s_mov_b32 s52, 0
    s_mov_b32 s53, 0
    s_mov_b32 s92, 1024
    s_mov_b32 s93, 8192
    s_mov_b32 s95, s61
    s_mov_b32 s83, s61
    s_mov_b64 s[96:97], 0
    s_mov_b64 s[98:99], 0
    s_mul_i32 s37, s27, 4352
    s_add_u32 s66, s68, s37
    s_addc_u32 s67, s69, 0
    s_lshl_b32 s29, s27, 2
    s_add_u32 s29, s29, s30
    s_lshl_b32 s28, s29, 8
    s_lshl_b32 s29, s29, 13
    s_add_u32 s14, s14, s29
    s_addc_u32 s15, s15, 0
    s_lshl_b32 s31, s61, 10
    v_lshl_add_u32 v58, v3, 4, s31
    v_lshl_add_u32 v51, v47, 5, v40
    s_lshl_b32 s37, s30, 9
    v_lshl_add_u32 v51, v51, 2, s37
    s_lshl_b32 s37, s30, 2
    v_lshl_add_u32 v52, v47, 6, s37
    s_mul_i32 s37, s30, 14848
    s_add_u32 s71, s37, 11648
    v_and_b32 v54, 60, v3
    v_add_u32 v54, s71, v54
    v_mov_b32 v43, 0xff7fffff
    v_mov_b32 v49, 11264
    v_and_b32 v40, 1, v3
    v_lshlrev_b32 v40, 4, v40
    v_mov_b32 v47, 0xffff
    v_lshlrev_b32 v40, v40, v47
    v_bfe_u32 v47, v3, 1, 3
    v_cmp_eq_u32 vcc, 0, v47
    s_nop 1
    v_cndmask_b32 v20, 0, v40, vcc
    v_cmp_eq_u32 vcc, 1, v47
    s_nop 1
    v_cndmask_b32 v21, 0, v40, vcc
    v_cmp_eq_u32 vcc, 2, v47
    s_nop 1
    v_cndmask_b32 v22, 0, v40, vcc
    v_cmp_eq_u32 vcc, 3, v47
    s_nop 1
    v_cndmask_b32 v23, 0, v40, vcc
    s_waitcnt vmcnt(8)
    ds_write_b128 v46, v[24:27] offset:8192
    s_waitcnt lgkmcnt(0)
    ds_read_b128 v[24:27], v50 offset:8192
    s_waitcnt lgkmcnt(0)
    v_bfe_u32 v46, v3, 2, 2
    v_cmp_eq_u32 vcc, 0, v46
    s_nop 1
    v_cndmask_b32 v4, 0, v24, vcc
    v_cndmask_b32 v5, 0, v25, vcc
    v_cndmask_b32 v6, 0, v26, vcc
    v_cndmask_b32 v7, 0, v27, vcc
    v_cmp_eq_u32 vcc, 1, v46
    s_nop 1
    v_cndmask_b32 v8, 0, v24, vcc
    v_cndmask_b32 v9, 0, v25, vcc
    v_cndmask_b32 v10, 0, v26, vcc
    v_cndmask_b32 v11, 0, v27, vcc
    v_cmp_eq_u32 vcc, 2, v46
    s_nop 1
    v_cndmask_b32 v12, 0, v24, vcc
    v_cndmask_b32 v13, 0, v25, vcc
    v_cndmask_b32 v14, 0, v26, vcc
    v_cndmask_b32 v15, 0, v27, vcc
    v_cmp_eq_u32 vcc, 3, v46
    s_nop 1
    v_cndmask_b32 v16, 0, v24, vcc
    v_cndmask_b32 v17, 0, v25, vcc
    v_cndmask_b32 v18, 0, v26, vcc
    v_cndmask_b32 v19, 0, v27, vcc
L_k:
    s_add_u32 s32, s32, 1
    s_cmp_eq_u32 s32, 9
    s_cbranch_scc1 L_decide
    s_cmp_lt_u32 s32, 9
    s_cbranch_scc1 L_k_on
    s_barrier
L_k_on:
    s_add_u32 s37, s32, s27
    s_and_b32 s37, s37, s49
    s_cselect_b32 s37, 0, s32
    s_cmp_ge_u32 s32, s52
    s_cselect_b32 s37, 0, s37
    s_cmp_lt_u32 s37, 9
    s_cselect_b32 s51, s92, s93
    s_cselect_b32 s100, s93, s92
    s_cselect_b32 s61, s95, s83
    s_add_u32 s101, s100, 65536
    s_lshr_b32 s24, s32, 2
    s_xor_b32 s37, s24, s61
    s_xor_b32 s37, s37, s63
    s_lshl_b32 s24, s24, 20
    s_bfe_u32 s38, s32, 65536
    s_lshl_b32 s38, s38, 9
    s_bfe_u32 s39, s32, 65537
    s_lshl_b32 s39, s39, 17
    s_or_b32 s38, s38, s39
    s_or_b32 s24, s24, s38
    s_bitcmp1_b32 s37, 0
    s_cselect_b32 s38, 524288, 0
    s_or_b32 s24, s24, s38
    s_bitcmp1_b32 s37, 1
    s_cselect_b32 s38, s51, 0
    s_or_b32 s24, s24, s38
    s_bitcmp1_b32 s37, 2
    s_cselect_b32 s38, 262144, 0
    s_or_b32 s24, s24, s38
    s_add_u32 s3, s24, 16384
    s_waitcnt vmcnt(4)
    v_mfma_f32_16x16x32_bf16 v[24:27], v[64:67], v[4:7], 0
    v_mfma_f32_16x16x32_bf16 v[24:27], v[68:71], v[8:11], v[24:27]
    v_mfma_f32_16x16x32_bf16 v[24:27], v[72:75], v[12:15], v[24:27]
    v_mfma_f32_16x16x32_bf16 v[24:27], v[76:79], v[16:19], v[24:27]
    buffer_load_dwordx4 v[64:67], v55, s[16:19], s24 offen nt
    s_add_u32 s89, s24, 65536
    buffer_load_dwordx4 v[68:71], v55, s[16:19], s89 offen nt
    s_add_u32 s90, s24, s100
    buffer_load_dwordx4 v[72:75], v55, s[16:19], s90 offen nt
    s_add_u32 s91, s24, s101
    buffer_load_dwordx4 v[76:79], v55, s[16:19], s91 offen nt
    s_nop 3
    v_mov_b32_dpp v40, v24 quad_perm:[0,0,0,0] row_mask:0xf bank_mask:0xf
    v_mov_b32_dpp v46, v26 quad_perm:[2,2,2,2] row_mask:0xf bank_mask:0xf
    s_nop 0
    v_add_f32_dpp v40, v25, v40 quad_perm:[1,1,1,1] row_mask:0xf bank_mask:0xf
    v_add_f32_dpp v46, v27, v46 quad_perm:[3,3,3,3] row_mask:0xf bank_mask:0xf
    v_add_f32 v40, v40, v46
    ds_write_b32 v54, v40
    v_max_f32 v43, v43, v40
    s_waitcnt vmcnt(4)
    v_mfma_f32_16x16x32_bf16 v[24:27], v[80:83], v[4:7], 0
    v_mfma_f32_16x16x32_bf16 v[24:27], v[84:87], v[8:11], v[24:27]
    v_mfma_f32_16x16x32_bf16 v[24:27], v[88:91], v[12:15], v[24:27]
    v_mfma_f32_16x16x32_bf16 v[24:27], v[92:95], v[16:19], v[24:27]
    buffer_load_dwordx4 v[80:83], v56, s[20:23], s3 offen nt
    s_add_u32 s89, s3, 65536
    buffer_load_dwordx4 v[84:87], v56, s[20:23], s89 offen nt
    s_add_u32 s90, s3, s100
    buffer_load_dwordx4 v[88:91], v56, s[20:23], s90 offen nt
    s_add_u32 s91, s3, s101
    buffer_load_dwordx4 v[92:95], v56, s[20:23], s91 offen nt
    s_nop 3
    v_mov_b32_dpp v57, v24 quad_perm:[0,0,0,0] row_mask:0xf bank_mask:0xf
    v_mov_b32_dpp v46, v26 quad_perm:[2,2,2,2] row_mask:0xf bank_mask:0xf
    s_nop 0
    v_add_f32_dpp v57, v25, v57 quad_perm:[1,1,1,1] row_mask:0xf bank_mask:0xf
    v_add_f32_dpp v46, v27, v46 quad_perm:[3,3,3,3] row_mask:0xf bank_mask:0xf
    v_add_f32 v57, v57, v46
    ds_write_b32 v54, v57 offset:64
    v_max_f32 v43, v43, v57
    v_add_u32 v54, 128, v54
    s_cmp_eq_u32 s32, s62
    s_cbranch_scc1 L_k_end
    s_and_b32 s37, s32, 15
    s_cbranch_scc1 L_k
L_k_head:
    s_nop 1
    v_max_f32_dpp v43, v43, v43 row_ror:4 row_mask:0xf bank_mask:0xf
    s_nop 1
    v_max_f32_dpp v43, v43, v43 row_ror:8 row_mask:0xf bank_mask:0xf
    s_nop 0
    v_readlane_b32 s56, v43, 0
    v_readlane_b32 s57, v43, 16
    v_readlane_b32 s58, v43, 32
    v_readlane_b32 s59, v43, 48
    s_nop 1
    v_max_f32 v43, s56, v43
    v_max_f32 v43, s57, v43
    v_max_f32 v43, s58, v43
    v_max_f32 v43, s59, v43
    s_lshl_b32 s38, s36, 8
    v_add_u32 v46, s38, v52
    ds_write_b32 v46, v43 offset:10240
    s_cmp_eq_u32 s32, s62
    s_cbranch_scc1 L_v_start
    s_add_u32 s36, s36, 1
    s_lshl_b32 s37, s36, 8
    v_add_u32 v47, s37, v50
    ds_read_b128 v[24:27], v47 offset:8192
    s_waitcnt lgkmcnt(0)
    v_mov_b32 v43, 0xff7fffff
    v_bfe_u32 v46, v3, 2, 2
    v_cmp_eq_u32 vcc, 0, v46
    s_nop 1
    v_cndmask_b32 v4, 0, v24, vcc
    v_cndmask_b32 v5, 0, v25, vcc
    v_cndmask_b32 v6, 0, v26, vcc
    v_cndmask_b32 v7, 0, v27, vcc
    v_cmp_eq_u32 vcc, 1, v46
    s_nop 1
    v_cndmask_b32 v8, 0, v24, vcc
    v_cndmask_b32 v9, 0, v25, vcc
    v_cndmask_b32 v10, 0, v26, vcc
    v_cndmask_b32 v11, 0, v27, vcc
    v_cmp_eq_u32 vcc, 2, v46
    s_nop 1
    v_cndmask_b32 v12, 0, v24, vcc
    v_cndmask_b32 v13, 0, v25, vcc
    v_cndmask_b32 v14, 0, v26, vcc
    v_cndmask_b32 v15, 0, v27, vcc
    v_cmp_eq_u32 vcc, 3, v46
    s_nop 1
    v_cndmask_b32 v16, 0, v24, vcc
    v_cndmask_b32 v17, 0, v25, vcc
    v_cndmask_b32 v18, 0, v26, vcc
    v_cndmask_b32 v19, 0, v27, vcc
    s_branch L_k
L_k_end:
    s_cmp_lg_u32 s53, 0
    s_cbranch_scc1 L_export
L_exported:
    s_add_u32 s34, s62, 1
    s_lshl_b32 s34, s34, 3
    s_or_b32 s34, s34, s61
    v_mov_b32 v59, 11328
    v_mov_b32 v48, s34
    ds_write_b32 v59, v48
    s_waitcnt lgkmcnt(0)
    s_cmp_lg_u32 s30, 0
    s_cbranch_scc1 L_kd
L_kd_claim:
    s_lshl_b32 s33, 1, s50
    s_atomic_add s33, s[66:67], 0x40 glc
L_kd:
    s_barrier
    s_mov_b32 s35, s34
    s_cmp_eq_u32 s30, 0
    s_cbranch_scc1 L_kd_have
    ds_read_b32 v53, v59
    s_waitcnt lgkmcnt(0)
    v_readfirstlane_b32 s35, v53
L_kd_have:
    v_add_u32 v59, 4, v59
    s_nop 0
    s_mov_b32 s25, s35
    s_cmp_ge_u32 s35, s48
    s_cbranch_scc1 L_kd_last
L_kd_go:
    s_lshr_b32 s29, s25, 3
    s_lshr_b32 s24, s29, 2
    s_xor_b32 s37, s24, s25
    s_xor_b32 s37, s37, s63
    s_lshl_b32 s24, s24, 20
    s_bfe_u32 s38, s29, 65536
    s_lshl_b32 s38, s38, 9
    s_bfe_u32 s39, s29, 65537
    s_lshl_b32 s39, s39, 17
    s_or_b32 s38, s38, s39
    s_or_b32 s24, s24, s38
    s_bitcmp1_b32 s37, 0
    s_cselect_b32 s38, 524288, 0
    s_or_b32 s24, s24, s38
    s_bitcmp1_b32 s37, 1
    s_cselect_b32 s38, s51, 0
    s_or_b32 s24, s24, s38
    s_bitcmp1_b32 s37, 2
    s_cselect_b32 s38, 262144, 0
    s_or_b32 s24, s24, s38
    s_add_u32 s3, s24, 16384
    s_waitcnt vmcnt(4)
    v_mfma_f32_16x16x32_bf16 v[24:27], v[64:67], v[4:7], 0
    v_mfma_f32_16x16x32_bf16 v[24:27], v[68:71], v[8:11], v[24:27]
    v_mfma_f32_16x16x32_bf16 v[24:27], v[72:75], v[12:15], v[24:27]
    v_mfma_f32_16x16x32_bf16 v[24:27], v[76:79], v[16:19], v[24:27]
    buffer_load_dwordx4 v[64:67], v55, s[16:19], s24 offen nt
    s_add_u32 s89, s24, 65536
    buffer_load_dwordx4 v[68:71], v55, s[16:19], s89 offen nt
    s_add_u32 s90, s24, s100
    buffer_load_dwordx4 v[72:75], v55, s[16:19], s90 offen nt
    s_add_u32 s91, s24, s101
    buffer_load_dwordx4 v[76:79], v55, s[16:19], s91 offen nt
    s_nop 3
    v_mov_b32_dpp v40, v24 quad_perm:[0,0,0,0] row_mask:0xf bank_mask:0xf
    v_mov_b32_dpp v46, v26 quad_perm:[2,2,2,2] row_mask:0xf bank_mask:0xf
    s_nop 0
    v_add_f32_dpp v40, v25, v40 quad_perm:[1,1,1,1] row_mask:0xf bank_mask:0xf
    v_add_f32_dpp v46, v27, v46 quad_perm:[3,3,3,3] row_mask:0xf bank_mask:0xf
    v_add_f32 v40, v40, v46
    ds_write_b32 v54, v40
    v_max_f32 v43, v43, v40
    s_waitcnt vmcnt(4)
    v_mfma_f32_16x16x32_bf16 v[24:27], v[80:83], v[4:7], 0
    v_mfma_f32_16x16x32_bf16 v[24:27], v[84:87], v[8:11], v[24:27]
    v_mfma_f32_16x16x32_bf16 v[24:27], v[88:91], v[12:15], v[24:27]
    v_mfma_f32_16x16x32_bf16 v[24:27], v[92:95], v[16:19], v[24:27]
    buffer_load_dwordx4 v[80:83], v56, s[20:23], s3 offen nt
    s_add_u32 s89, s3, 65536
    buffer_load_dwordx4 v[84:87], v56, s[20:23], s89 offen nt
    s_add_u32 s90, s3, s100
    buffer_load_dwordx4 v[88:91], v56, s[20:23], s90 offen nt
    s_add_u32 s91, s3, s101
    buffer_load_dwordx4 v[92:95], v56, s[20:23], s91 offen nt
    s_nop 3
    v_mov_b32_dpp v57, v24 quad_perm:[0,0,0,0] row_mask:0xf bank_mask:0xf
    v_mov_b32_dpp v46, v26 quad_perm:[2,2,2,2] row_mask:0xf bank_mask:0xf
    s_nop 0
    v_add_f32_dpp v57, v25, v57 quad_perm:[1,1,1,1] row_mask:0xf bank_mask:0xf
    v_add_f32_dpp v46, v27, v46 quad_perm:[3,3,3,3] row_mask:0xf bank_mask:0xf
    v_add_f32 v57, v57, v46
    ds_write_b32 v54, v57 offset:64
    v_max_f32 v43, v43, v57
    v_add_u32 v54, 128, v54
    s_cmp_ge_u32 s35, s48
    s_cbranch_scc1 L_k_head
    s_cmp_lg_u32 s30, 0
    s_cbranch_scc1 L_kd
    s_waitcnt lgkmcnt(0)
    s_lshr_b32 s33, s33, s50
    s_and_b32 s33, s33, 255
    s_lshr_b32 s34, s33, 1
    s_lshl_b32 s34, s34, 2
    s_and_b32 s37, s33, 1
    s_or_b32 s34, s34, s37
    s_and_b32 s37, s61, 2
    s_or_b32 s34, s34, s37
    s_cmp_eq_u32 s82, 0
    s_cselect_b32 s34, s34, s33
    s_lshl_b32 s37, s62, 3
    s_add_u32 s34, s34, s37
    s_add_u32 s34, s34, 16
    v_mov_b32 v48, s34
    ds_write_b32 v59, v48
    s_waitcnt lgkmcnt(0)
    s_cmp_lt_u32 s34, s48
    s_cbranch_scc1 L_kd_claim
    s_branch L_kd
L_kd_last:
    s_mov_b64 s[16:17], s[8:9]
    s_mov_b64 s[20:21], s[8:9]
    v_mov_b32 v55, v2
    v_mov_b32 v56, v2
    s_mov_b32 s51, 1024
    s_and_b32 s61, s2, 7
    s_mov_b32 s100, 8192
    s_mov_b32 s101, 73728
    s_mov_b32 s25, s61
    s_branch L_kd_go
L_v_start:
    s_mov_b32 s32, 0
    v_and_b32 v54, 60, v3
    v_add_u32 v54, s71, v54
    s_mov_b32 s36, 0
    s_cmp_eq_u32 s53, 0
    s_cbranch_scc1 L_v_head
    s_xor_b32 s83, s83, s53
    s_lshl_b32 s37, s27, 3
    s_or_b32 s37, s37, s83
    s_lshl_b32 s37, s37, 2
    s_or_b32 s37, s37, s30
    s_lshl_b32 s37, s37, 10
    s_add_u32 s37, s37, 0x200000
    v_lshl_add_u32 v47, v3, 4, s37
    global_load_dwordx4 v[100:103], v47, s[68:69] sc1
L_v_head:
    s_lshl_b32 s38, s36, 8
    v_add_u32 v46, s38, v52
    s_waitcnt lgkmcnt(0)
    ds_read_b32 v43, v46 offset:10240
    v_mov_b32 v28, 0
    v_mov_b32 v29, 0
    v_mov_b32 v30, 0
    v_mov_b32 v31, 0
    v_mov_b32 v45, 0
    s_waitcnt lgkmcnt(0)
    v_mul_f32 v44, s26, v43
L_v:
    s_barrier
    ds_read_b32 v40, v54
    ds_read_b32 v57, v54 offset:64
    s_add_u32 s32, s32, 1
    s_cmp_eq_u32 s32, 9
    s_cbranch_scc1 L_import
L_v_on:
    s_add_u32 s37, s32, s27
    s_and_b32 s37, s37, s49
    s_cselect_b32 s37, 0, s32
    s_cmp_ge_u32 s32, s52
    s_cselect_b32 s37, 0, s37
    s_cmp_lt_u32 s37, 9
    s_cselect_b32 s51, s92, s93
    s_cselect_b32 s100, s93, s92
    s_cselect_b32 s61, s95, s83
    s_add_u32 s101, s100, 65536
    s_lshr_b32 s24, s32, 2
    s_xor_b32 s37, s24, s61
    s_xor_b32 s37, s37, s63
    s_lshl_b32 s24, s24, 20
    s_bfe_u32 s38, s32, 65536
    s_lshl_b32 s38, s38, 9
    s_bfe_u32 s39, s32, 65537
    s_lshl_b32 s39, s39, 17
    s_or_b32 s38, s38, s39
    s_or_b32 s24, s24, s38
    s_bitcmp1_b32 s37, 0
    s_cselect_b32 s38, 524288, 0
    s_or_b32 s24, s24, s38
    s_bitcmp1_b32 s37, 1
    s_cselect_b32 s38, s51, 0
    s_or_b32 s24, s24, s38
    s_bitcmp1_b32 s37, 2
    s_cselect_b32 s38, 262144, 0
    s_or_b32 s24, s24, s38
    s_add_u32 s3, s24, 16384
    v_add_u32 v54, 128, v54
    s_waitcnt lgkmcnt(0)
    v_fma_f32 v41, v40, s26, -v44
    v_exp_f32 v41, v41
    s_nop 0
    v_cvt_pk_bf16_f32 v42, v41, v41
    v_add_f32 v45, v45, v41
    s_nop 0
    v_and_b32_dpp v32, v42, v20 row_newbcast:0 row_mask:0xf bank_mask:0xf
    v_and_b32_dpp v33, v42, v21 row_newbcast:0 row_mask:0xf bank_mask:0xf
    v_and_b32_dpp v34, v42, v22 row_newbcast:0 row_mask:0xf bank_mask:0xf
    v_and_b32_dpp v35, v42, v23 row_newbcast:0 row_mask:0xf bank_mask:0xf
    v_and_b32_dpp v36, v42, v20 row_newbcast:4 row_mask:0xf bank_mask:0xf
    v_and_b32_dpp v37, v42, v21 row_newbcast:4 row_mask:0xf bank_mask:0xf
    v_and_b32_dpp v38, v42, v22 row_newbcast:4 row_mask:0xf bank_mask:0xf
    v_and_b32_dpp v39, v42, v23 row_newbcast:4 row_mask:0xf bank_mask:0xf
    s_waitcnt vmcnt(4)
    v_mfma_f32_16x16x32_bf16 v[28:31], v[64:67], v[32:35], v[28:31]
    v_and_b32_dpp v32, v42, v20 row_newbcast:8 row_mask:0xf bank_mask:0xf
    v_and_b32_dpp v33, v42, v21 row_newbcast:8 row_mask:0xf bank_mask:0xf
    v_and_b32_dpp v34, v42, v22 row_newbcast:8 row_mask:0xf bank_mask:0xf
    v_and_b32_dpp v35, v42, v23 row_newbcast:8 row_mask:0xf bank_mask:0xf
    v_mfma_f32_16x16x32_bf16 v[28:31], v[68:71], v[36:39], v[28:31]
    v_and_b32_dpp v36, v42, v20 row_newbcast:12 row_mask:0xf bank_mask:0xf
    v_and_b32_dpp v37, v42, v21 row_newbcast:12 row_mask:0xf bank_mask:0xf
    v_and_b32_dpp v38, v42, v22 row_newbcast:12 row_mask:0xf bank_mask:0xf
    v_and_b32_dpp v39, v42, v23 row_newbcast:12 row_mask:0xf bank_mask:0xf
    v_mfma_f32_16x16x32_bf16 v[28:31], v[72:75], v[32:35], v[28:31]
    s_nop 0
    v_mfma_f32_16x16x32_bf16 v[28:31], v[76:79], v[36:39], v[28:31]
    buffer_load_dwordx4 v[64:67], v55, s[16:19], s24 offen nt
    s_add_u32 s89, s24, 65536
    buffer_load_dwordx4 v[68:71], v55, s[16:19], s89 offen nt
    s_add_u32 s90, s24, s100
    buffer_load_dwordx4 v[72:75], v55, s[16:19], s90 offen nt
    s_add_u32 s91, s24, s101
    buffer_load_dwordx4 v[76:79], v55, s[16:19], s91 offen nt
    v_fma_f32 v41, v57, s26, -v44
    v_exp_f32 v41, v41
    s_nop 0
    v_cvt_pk_bf16_f32 v42, v41, v41
    v_add_f32 v45, v45, v41
    s_nop 0
    v_and_b32_dpp v32, v42, v20 row_newbcast:0 row_mask:0xf bank_mask:0xf
    v_and_b32_dpp v33, v42, v21 row_newbcast:0 row_mask:0xf bank_mask:0xf
    v_and_b32_dpp v34, v42, v22 row_newbcast:0 row_mask:0xf bank_mask:0xf
    v_and_b32_dpp v35, v42, v23 row_newbcast:0 row_mask:0xf bank_mask:0xf
    v_and_b32_dpp v36, v42, v20 row_newbcast:4 row_mask:0xf bank_mask:0xf
    v_and_b32_dpp v37, v42, v21 row_newbcast:4 row_mask:0xf bank_mask:0xf
    v_and_b32_dpp v38, v42, v22 row_newbcast:4 row_mask:0xf bank_mask:0xf
    v_and_b32_dpp v39, v42, v23 row_newbcast:4 row_mask:0xf bank_mask:0xf
    s_waitcnt vmcnt(4)
    v_mfma_f32_16x16x32_bf16 v[28:31], v[80:83], v[32:35], v[28:31]
    v_and_b32_dpp v32, v42, v20 row_newbcast:8 row_mask:0xf bank_mask:0xf
    v_and_b32_dpp v33, v42, v21 row_newbcast:8 row_mask:0xf bank_mask:0xf
    v_and_b32_dpp v34, v42, v22 row_newbcast:8 row_mask:0xf bank_mask:0xf
    v_and_b32_dpp v35, v42, v23 row_newbcast:8 row_mask:0xf bank_mask:0xf
    v_mfma_f32_16x16x32_bf16 v[28:31], v[84:87], v[36:39], v[28:31]
    v_and_b32_dpp v36, v42, v20 row_newbcast:12 row_mask:0xf bank_mask:0xf
    v_and_b32_dpp v37, v42, v21 row_newbcast:12 row_mask:0xf bank_mask:0xf
    v_and_b32_dpp v38, v42, v22 row_newbcast:12 row_mask:0xf bank_mask:0xf
    v_and_b32_dpp v39, v42, v23 row_newbcast:12 row_mask:0xf bank_mask:0xf
    v_mfma_f32_16x16x32_bf16 v[28:31], v[88:91], v[32:35], v[28:31]
    s_nop 0
    v_mfma_f32_16x16x32_bf16 v[28:31], v[92:95], v[36:39], v[28:31]
    buffer_load_dwordx4 v[80:83], v56, s[20:23], s3 offen nt
    s_add_u32 s89, s3, 65536
    buffer_load_dwordx4 v[84:87], v56, s[20:23], s89 offen nt
    s_add_u32 s90, s3, s100
    buffer_load_dwordx4 v[88:91], v56, s[20:23], s90 offen nt
    s_add_u32 s91, s3, s101
    buffer_load_dwordx4 v[92:95], v56, s[20:23], s91 offen nt
    s_cmp_eq_u32 s32, s62
    s_cbranch_scc1 L_v_done
    s_and_b32 s37, s32, 15
    s_cbranch_scc1 L_v
    s_nop 1
    v_add_f32_dpp v45, v45, v45 row_ror:4 row_mask:0xf bank_mask:0xf
    s_mul_i32 s37, s36, 2048
    s_lshl_b32 s38, s36, 8
    v_add_f32_dpp v45, v45, v45 row_ror:8 row_mask:0xf bank_mask:0xf
    v_add_u32 v47, s37, v51
    v_add_u32 v46, s38, v52
    s_mov_b32 exec_lo, 0x00ff00ff
    s_mov_b32 exec_hi, 0x00ff00ff
    ds_write_b32 v47, v28 offset:0
    ds_write_b32 v47, v29 offset:32
    ds_write_b32 v47, v30 offset:64
    ds_write_b32 v47, v31 offset:96
    s_mov_b32 exec_lo, 0x00010001
    s_mov_b32 exec_hi, 0x00010001
    ds_write_b32 v46, v45 offset:9216
    ds_write_b32 v46, v43 offset:10240
    s_mov_b64 exec, -1
    s_add_u32 s36, s36, 1
    s_branch L_v_head
L_vd_last:
    s_mov_b64 s[16:17], s[6:7]
    v_mov_b32 v55, v1
    s_lshr_b32 s24, s62, 2
    s_xor_b32 s37, s24, s61
    s_xor_b32 s37, s37, s63
    s_lshl_b32 s24, s24, 20
    s_bfe_u32 s38, s62, 65536
    s_lshl_b32 s38, s38, 9
    s_bfe_u32 s39, s62, 65537
    s_lshl_b32 s39, s39, 17
    s_or_b32 s38, s38, s39
    s_or_b32 s24, s24, s38
    s_bitcmp1_b32 s37, 0
    s_cselect_b32 s38, 524288, 0
    s_or_b32 s24, s24, s38
    s_bitcmp1_b32 s37, 1
    s_cselect_b32 s38, s51, 0
    s_or_b32 s24, s24, s38
    s_bitcmp1_b32 s37, 2
    s_cselect_b32 s38, 262144, 0
    s_or_b32 s24, s24, s38
    s_mov_b32 s3, s24
    s_branch L_vd_go
L_v_done:
    s_cmp_lg_u32 s30, 1
    s_cbranch_scc1 L_wb
    s_getpc_b64 s[72:73]
L_pcb:
    s_sub_u32 s72, s72, L_pcb-standalone__softmax_full_bidir__decode_kernel
    s_subb_u32 s73, s73, 0
    v_lshlrev_b32 v96, 7, v3
    v_min_u32 v96, L_last-standalone__softmax_full_bidir__decode_kernel, v96
    global_load_dword v97, v96, s[72:73]
L_wb:
    s_lshr_b32 s62, s48, 3
    v_mov_b32 v59, 11328
L_vd:
    ds_read_b32 v53, v59
    ds_read_b32 v40, v54
    ds_read_b32 v57, v54 offset:64
    v_add_u32 v59, 4, v59
    v_add_u32 v54, 128, v54
    s_waitcnt lgkmcnt(0)
    v_readfirstlane_b32 s35, v53
    s_nop 1
    s_cmp_ge_u32 s35, s48
    s_cbranch_scc1 L_vd_last
    s_lshr_b32 s29, s35, 3
    s_lshr_b32 s24, s29, 2
    s_xor_b32 s37, s24, s35
    s_xor_b32 s37, s37, s63
    s_lshl_b32 s24, s24, 20
    s_bfe_u32 s38, s29, 65536
    s_lshl_b32 s38, s38, 9
    s_bfe_u32 s39, s29, 65537
    s_lshl_b32 s39, s39, 17
    s_or_b32 s38, s38, s39
    s_or_b32 s24, s24, s38
    s_bitcmp1_b32 s37, 0
    s_cselect_b32 s38, 524288, 0
    s_or_b32 s24, s24, s38
    s_bitcmp1_b32 s37, 1
    s_cselect_b32 s38, s51, 0
    s_or_b32 s24, s24, s38
    s_bitcmp1_b32 s37, 2
    s_cselect_b32 s38, 262144, 0
    s_or_b32 s24, s24, s38
    s_add_u32 s3, s24, 16384
L_vd_go:
    v_fma_f32 v41, v40, s26, -v44
    v_exp_f32 v41, v41
    s_nop 0
    v_cvt_pk_bf16_f32 v42, v41, v41
    v_add_f32 v45, v45, v41
    s_nop 0
    v_and_b32_dpp v32, v42, v20 row_newbcast:0 row_mask:0xf bank_mask:0xf
    v_and_b32_dpp v33, v42, v21 row_newbcast:0 row_mask:0xf bank_mask:0xf
    v_and_b32_dpp v34, v42, v22 row_newbcast:0 row_mask:0xf bank_mask:0xf
    v_and_b32_dpp v35, v42, v23 row_newbcast:0 row_mask:0xf bank_mask:0xf
    v_and_b32_dpp v36, v42, v20 row_newbcast:4 row_mask:0xf bank_mask:0xf
    v_and_b32_dpp v37, v42, v21 row_newbcast:4 row_mask:0xf bank_mask:0xf
    v_and_b32_dpp v38, v42, v22 row_newbcast:4 row_mask:0xf bank_mask:0xf
    v_and_b32_dpp v39, v42, v23 row_newbcast:4 row_mask:0xf bank_mask:0xf
    s_waitcnt vmcnt(4)
    v_mfma_f32_16x16x32_bf16 v[28:31], v[64:67], v[32:35], v[28:31]
    v_and_b32_dpp v32, v42, v20 row_newbcast:8 row_mask:0xf bank_mask:0xf
    v_and_b32_dpp v33, v42, v21 row_newbcast:8 row_mask:0xf bank_mask:0xf
    v_and_b32_dpp v34, v42, v22 row_newbcast:8 row_mask:0xf bank_mask:0xf
    v_and_b32_dpp v35, v42, v23 row_newbcast:8 row_mask:0xf bank_mask:0xf
    v_mfma_f32_16x16x32_bf16 v[28:31], v[68:71], v[36:39], v[28:31]
    v_and_b32_dpp v36, v42, v20 row_newbcast:12 row_mask:0xf bank_mask:0xf
    v_and_b32_dpp v37, v42, v21 row_newbcast:12 row_mask:0xf bank_mask:0xf
    v_and_b32_dpp v38, v42, v22 row_newbcast:12 row_mask:0xf bank_mask:0xf
    v_and_b32_dpp v39, v42, v23 row_newbcast:12 row_mask:0xf bank_mask:0xf
    v_mfma_f32_16x16x32_bf16 v[28:31], v[72:75], v[32:35], v[28:31]
    s_nop 0
    v_mfma_f32_16x16x32_bf16 v[28:31], v[76:79], v[36:39], v[28:31]
    buffer_load_dwordx4 v[64:67], v55, s[16:19], s24 offen nt
    s_add_u32 s89, s24, 65536
    buffer_load_dwordx4 v[68:71], v55, s[16:19], s89 offen nt
    s_add_u32 s90, s24, s100
    buffer_load_dwordx4 v[72:75], v55, s[16:19], s90 offen nt
    s_add_u32 s91, s24, s101
    buffer_load_dwordx4 v[76:79], v55, s[16:19], s91 offen nt
    v_fma_f32 v41, v57, s26, -v44
    v_exp_f32 v41, v41
    s_nop 0
    v_cvt_pk_bf16_f32 v42, v41, v41
    v_add_f32 v45, v45, v41
    s_nop 0
    v_and_b32_dpp v32, v42, v20 row_newbcast:0 row_mask:0xf bank_mask:0xf
    v_and_b32_dpp v33, v42, v21 row_newbcast:0 row_mask:0xf bank_mask:0xf
    v_and_b32_dpp v34, v42, v22 row_newbcast:0 row_mask:0xf bank_mask:0xf
    v_and_b32_dpp v35, v42, v23 row_newbcast:0 row_mask:0xf bank_mask:0xf
    v_and_b32_dpp v36, v42, v20 row_newbcast:4 row_mask:0xf bank_mask:0xf
    v_and_b32_dpp v37, v42, v21 row_newbcast:4 row_mask:0xf bank_mask:0xf
    v_and_b32_dpp v38, v42, v22 row_newbcast:4 row_mask:0xf bank_mask:0xf
    v_and_b32_dpp v39, v42, v23 row_newbcast:4 row_mask:0xf bank_mask:0xf
    s_waitcnt vmcnt(4)
    v_mfma_f32_16x16x32_bf16 v[28:31], v[80:83], v[32:35], v[28:31]
    v_and_b32_dpp v32, v42, v20 row_newbcast:8 row_mask:0xf bank_mask:0xf
    v_and_b32_dpp v33, v42, v21 row_newbcast:8 row_mask:0xf bank_mask:0xf
    v_and_b32_dpp v34, v42, v22 row_newbcast:8 row_mask:0xf bank_mask:0xf
    v_and_b32_dpp v35, v42, v23 row_newbcast:8 row_mask:0xf bank_mask:0xf
    v_mfma_f32_16x16x32_bf16 v[28:31], v[84:87], v[36:39], v[28:31]
    v_and_b32_dpp v36, v42, v20 row_newbcast:12 row_mask:0xf bank_mask:0xf
    v_and_b32_dpp v37, v42, v21 row_newbcast:12 row_mask:0xf bank_mask:0xf
    v_and_b32_dpp v38, v42, v22 row_newbcast:12 row_mask:0xf bank_mask:0xf
    v_and_b32_dpp v39, v42, v23 row_newbcast:12 row_mask:0xf bank_mask:0xf
    v_mfma_f32_16x16x32_bf16 v[28:31], v[88:91], v[32:35], v[28:31]
    s_nop 0
    v_mfma_f32_16x16x32_bf16 v[28:31], v[92:95], v[36:39], v[28:31]
    buffer_load_dwordx4 v[80:83], v56, s[20:23], s3 offen nt
    s_add_u32 s89, s3, 65536
    buffer_load_dwordx4 v[84:87], v56, s[20:23], s89 offen nt
    s_add_u32 s90, s3, s100
    buffer_load_dwordx4 v[88:91], v56, s[20:23], s90 offen nt
    s_add_u32 s91, s3, s101
    buffer_load_dwordx4 v[92:95], v56, s[20:23], s91 offen nt
    s_cmp_lt_u32 s35, s48
    s_cbranch_scc1 L_vd
    s_lshl_b32 s25, s62, 4
    s_lshl_b32 s37, s61, 1
    s_or_b32 s25, s25, s37
    s_or_b32 s34, s25, 1
    v_mov_b32 v48, s34
    ds_write_b32 v49, v48
    s_and_b32 s84, s61, 2
    s_sub_u32 s85, 63, s62
    s_lshl_b32 s85, s85, 3
    s_waitcnt lgkmcnt(0)
    s_cmp_eq_u32 s30, 0
    s_cbranch_scc1 L_t_claim
L_round:
    s_cmp_ge_u32 s25, 0x400
    s_cbranch_scc1 L_epi
    s_barrier
    s_mov_b32 s35, s34
    s_cmp_eq_u32 s30, 0
    s_cbranch_scc1 L_have
    ds_read_b32 v53, v49
    s_waitcnt lgkmcnt(0)
    v_readfirstlane_b32 s35, v53
L_have:
    v_xor_b32 v49, 4, v49
    s_nop 0
    s_cmp_lt_u32 s35, 0x400
    s_cselect_b32 s18, 16777216, 0
    s_cselect_b32 s22, 16777216, 0
    s_bfe_u32 s29, s35, 0x60004
    s_lshr_b32 s3, s35, 1
    s_lshr_b32 s24, s29, 2
    s_xor_b32 s37, s24, s3
    s_xor_b32 s37, s37, s63
    s_lshl_b32 s24, s24, 20
    s_bfe_u32 s38, s29, 65536
    s_lshl_b32 s38, s38, 9
    s_bfe_u32 s39, s29, 65537
    s_lshl_b32 s39, s39, 17
    s_or_b32 s38, s38, s39
    s_or_b32 s24, s24, s38
    s_bitcmp1_b32 s37, 0
    s_cselect_b32 s38, 524288, 0
    s_or_b32 s24, s24, s38
    s_bitcmp1_b32 s37, 1
    s_cselect_b32 s38, s51, 0
    s_or_b32 s24, s24, s38
    s_bitcmp1_b32 s37, 2
    s_cselect_b32 s38, 262144, 0
    s_or_b32 s24, s24, s38
    s_and_b32 s3, s35, 1
    s_lshl_b32 s3, s3, 14
    s_or_b32 s24, s24, s3
    s_mov_b32 s3, s24
    s_waitcnt vmcnt(4)
    v_mfma_f32_16x16x32_bf16 v[24:27], v[64:67], v[4:7], 0
    v_mfma_f32_16x16x32_bf16 v[24:27], v[68:71], v[8:11], v[24:27]
    v_mfma_f32_16x16x32_bf16 v[24:27], v[72:75], v[12:15], v[24:27]
    v_mfma_f32_16x16x32_bf16 v[24:27], v[76:79], v[16:19], v[24:27]
    buffer_load_dwordx4 v[64:67], v55, s[16:19], s24 offen nt
    s_add_u32 s89, s24, 65536
    buffer_load_dwordx4 v[68:71], v55, s[16:19], s89 offen nt
    s_add_u32 s90, s24, s100
    buffer_load_dwordx4 v[72:75], v55, s[16:19], s90 offen nt
    s_add_u32 s91, s24, s101
    buffer_load_dwordx4 v[76:79], v55, s[16:19], s91 offen nt
    s_nop 3
    v_mov_b32_dpp v40, v24 quad_perm:[0,0,0,0] row_mask:0xf bank_mask:0xf
    v_mov_b32_dpp v46, v26 quad_perm:[2,2,2,2] row_mask:0xf bank_mask:0xf
    s_nop 0
    v_add_f32_dpp v40, v25, v40 quad_perm:[1,1,1,1] row_mask:0xf bank_mask:0xf
    v_add_f32_dpp v46, v27, v46 quad_perm:[3,3,3,3] row_mask:0xf bank_mask:0xf
    v_add_f32 v40, v40, v46
    v_cmp_gt_f32 vcc, v40, v43
    s_cbranch_vccnz L_slow
L_back:
    v_fma_f32 v41, v40, s26, -v44
    v_exp_f32 v41, v41
    s_nop 0
    v_cvt_pk_bf16_f32 v42, v41, v41
    v_add_f32 v45, v45, v41
    s_nop 0
    v_and_b32_dpp v32, v42, v20 row_newbcast:0 row_mask:0xf bank_mask:0xf
    v_and_b32_dpp v33, v42, v21 row_newbcast:0 row_mask:0xf bank_mask:0xf
    v_and_b32_dpp v34, v42, v22 row_newbcast:0 row_mask:0xf bank_mask:0xf
    v_and_b32_dpp v35, v42, v23 row_newbcast:0 row_mask:0xf bank_mask:0xf
    v_and_b32_dpp v36, v42, v20 row_newbcast:4 row_mask:0xf bank_mask:0xf
    v_and_b32_dpp v37, v42, v21 row_newbcast:4 row_mask:0xf bank_mask:0xf
    v_and_b32_dpp v38, v42, v22 row_newbcast:4 row_mask:0xf bank_mask:0xf
    v_and_b32_dpp v39, v42, v23 row_newbcast:4 row_mask:0xf bank_mask:0xf
    s_waitcnt vmcnt(4)
    v_mfma_f32_16x16x32_bf16 v[28:31], v[80:83], v[32:35], v[28:31]
    v_and_b32_dpp v32, v42, v20 row_newbcast:8 row_mask:0xf bank_mask:0xf
    v_and_b32_dpp v33, v42, v21 row_newbcast:8 row_mask:0xf bank_mask:0xf
    v_and_b32_dpp v34, v42, v22 row_newbcast:8 row_mask:0xf bank_mask:0xf
    v_and_b32_dpp v35, v42, v23 row_newbcast:8 row_mask:0xf bank_mask:0xf
    v_mfma_f32_16x16x32_bf16 v[28:31], v[84:87], v[36:39], v[28:31]
    v_and_b32_dpp v36, v42, v20 row_newbcast:12 row_mask:0xf bank_mask:0xf
    v_and_b32_dpp v37, v42, v21 row_newbcast:12 row_mask:0xf bank_mask:0xf
    v_and_b32_dpp v38, v42, v22 row_newbcast:12 row_mask:0xf bank_mask:0xf
    v_and_b32_dpp v39, v42, v23 row_newbcast:12 row_mask:0xf bank_mask:0xf
    v_mfma_f32_16x16x32_bf16 v[28:31], v[88:91], v[32:35], v[28:31]
    s_nop 0
    v_mfma_f32_16x16x32_bf16 v[28:31], v[92:95], v[36:39], v[28:31]
    buffer_load_dwordx4 v[80:83], v56, s[20:23], s3 offen nt
    s_add_u32 s89, s3, 65536
    buffer_load_dwordx4 v[84:87], v56, s[20:23], s89 offen nt
    s_add_u32 s90, s3, s100
    buffer_load_dwordx4 v[88:91], v56, s[20:23], s90 offen nt
    s_add_u32 s91, s3, s101
    buffer_load_dwordx4 v[92:95], v56, s[20:23], s91 offen nt
    s_mov_b32 s25, s35
    s_cmp_lg_u32 s30, 0
    s_cbranch_scc1 L_round
    s_branch L_ticket
L_epi:
    v_lshlrev_b32 v48, 4, v3
    s_cmp_lg_u32 s25, 8199
    s_cbranch_scc1 L_epi2
    s_mov_b64 s[16:17], s[14:15]
    s_mov_b32 s18, 8192
    s_add_u32 s73, s31, 1024
    s_and_b32 s73, s73, 8191
    s_add_u32 s74, s31, 2048
    s_and_b32 s74, s74, 8191
    s_add_u32 s75, s31, 3072
    s_and_b32 s75, s75, 8191
    s_add_u32 s76, s31, 4096
    s_and_b32 s76, s76, 8191
    s_add_u32 s77, s31, 5120
    s_and_b32 s77, s77, 8191
    s_add_u32 s78, s31, 6144
    s_and_b32 s78, s78, 8191
    s_add_u32 s79, s31, 7168
    s_and_b32 s79, s79, 8191
    buffer_load_dwordx4 v[96:99], v48, s[16:19], s73 offen sc1
    buffer_load_dwordx4 v[100:103], v48, s[16:19], s74 offen sc1
    buffer_load_dwordx4 v[104:107], v48, s[16:19], s75 offen sc1
    buffer_load_dwordx4 v[108:111], v48, s[16:19], s76 offen sc1
    buffer_load_dwordx4 v[112:115], v48, s[16:19], s77 offen sc1
    buffer_load_dwordx4 v[116:119], v48, s[16:19], s78 offen sc1
    buffer_load_dwordx4 v[120:123], v48, s[16:19], s79 offen sc1
L_epi2:
    s_nop 1
    v_add_f32_dpp v45, v45, v45 row_ror:4 row_mask:0xf bank_mask:0xf
    s_mul_i32 s37, s36, 2048
    s_lshl_b32 s38, s36, 8
    v_add_f32_dpp v45, v45, v45 row_ror:8 row_mask:0xf bank_mask:0xf
    v_add_u32 v47, s37, v51
    v_add_u32 v46, s38, v52
    s_mov_b32 exec_lo, 0x00ff00ff
    s_mov_b32 exec_hi, 0x00ff00ff
    ds_write_b32 v47, v28 offset:0
    ds_write_b32 v47, v29 offset:32
    ds_write_b32 v47, v30 offset:64
    ds_write_b32 v47, v31 offset:96
    s_mov_b32 exec_lo, 0x00010001
    s_mov_b32 exec_hi, 0x00010001
    ds_write_b32 v46, v45 offset:9216
    ds_write_b32 v46, v43 offset:10240
    s_mov_b64 exec, -1
    s_waitcnt lgkmcnt(0)
    s_barrier
    s_mul_i32 s37, s30, 2048
    s_lshl_b32 s38, s30, 8
    v_and_b32 v40, 51, v3
    v_lshl_add_u32 v40, v40, 2, s38
    v_lshl_add_u32 v46, v3, 3, s37
    ds_read_b32 v43, v40 offset:10240
    ds_read_b32 v45, v40 offset:9216
    v_mov_b32 v49, 11272
    ds_read_b32 v53, v49
    ds_read_b64 v[32:33], v46 offset:0
    ds_read_b64 v[34:35], v46 offset:512
    ds_read_b64 v[36:37], v46 offset:1024
    ds_read_b64 v[38:39], v46 offset:1536
    s_waitcnt lgkmcnt(4)
    v_mov_b32 v44, v43
    s_nop 1
    v_max_f32_dpp v44, v44, v44 row_ror:1 row_mask:0xf bank_mask:0xf
    s_nop 1
    v_max_f32_dpp v44, v44, v44 row_ror:2 row_mask:0xf bank_mask:0xf
    v_sub_f32 v41, v43, v44
    v_mul_f32 v41, s26, v41
    v_exp_f32 v41, v41
    s_nop 0
    v_mul_f32 v45, v45, v41
    s_nop 1
    v_add_f32_dpp v45, v45, v45 row_ror:1 row_mask:0xf bank_mask:0xf
    s_nop 1
    v_add_f32_dpp v45, v45, v45 row_ror:2 row_mask:0xf bank_mask:0xf
    s_nop 0
    v_readlane_b32 s32, v45, 0
    v_readlane_b32 s33, v45, 16
    v_readlane_b32 s34, v45, 32
    v_readlane_b32 s35, v45, 48
    v_readlane_b32 s48, v41, 0
    v_readlane_b32 s49, v41, 1
    v_readlane_b32 s50, v41, 2
    v_readlane_b32 s51, v41, 3
    v_mov_b32 v31, s32
    v_add_f32 v31, s33, v31
    v_add_f32 v31, s34, v31
    v_add_f32 v31, s35, v31
    v_mov_b32 v30, v44
    s_waitcnt lgkmcnt(0)
    v_mul_f32 v28, s48, v32
    v_mul_f32 v29, s48, v33
    v_fmac_f32 v28, s49, v34
    v_fmac_f32 v29, s49, v35
    v_fmac_f32 v28, s50, v36
    v_fmac_f32 v29, s50, v37
    v_fmac_f32 v28, s51, v38
    v_fmac_f32 v29, s51, v39
    s_cmp_eq_u32 s25, 8199
    s_cbranch_scc1 L_merge
    v_and_b32 v40, 1, v3
    v_cmp_eq_u32 vcc, 1, v40
    s_nop 1
    v_cndmask_b32 v30, v30, v31, vcc
    v_mov_b32 v31, v53
    global_store_dwordx4 v58, v[28:31], s[14:15] sc1
    s_branch L_fin
L_again:
    buffer_load_dwordx4 v[96:99], v48, s[16:19], s73 offen sc1
    buffer_load_dwordx4 v[100:103], v48, s[16:19], s74 offen sc1
    buffer_load_dwordx4 v[104:107], v48, s[16:19], s75 offen sc1
    buffer_load_dwordx4 v[108:111], v48, s[16:19], s76 offen sc1
    buffer_load_dwordx4 v[112:115], v48, s[16:19], s77 offen sc1
    buffer_load_dwordx4 v[116:119], v48, s[16:19], s78 offen sc1
    buffer_load_dwordx4 v[120:123], v48, s[16:19], s79 offen sc1
L_merge:
    s_waitcnt vmcnt(0)
    v_xor_b32 v99, v99, v53
    v_xor_b32 v103, v103, v53
    v_xor_b32 v107, v107, v53
    v_xor_b32 v111, v111, v53
    v_xor_b32 v115, v115, v53
    v_xor_b32 v119, v119, v53
    v_xor_b32 v123, v123, v53
    v_or3_b32 v40, v99, v103, v107
    v_or3_b32 v40, v40, v111, v115
    v_or3_b32 v40, v40, v119, v123
    v_cmp_ne_u32 vcc, 0, v40
    s_cbranch_vccnz L_again
    v_mov_b32_dpp v99, v98 quad_perm:[1,1,3,3] row_mask:0xf bank_mask:0xf
    v_mov_b32_dpp v103, v102 quad_perm:[1,1,3,3] row_mask:0xf bank_mask:0xf
    v_mov_b32_dpp v107, v106 quad_perm:[1,1,3,3] row_mask:0xf bank_mask:0xf
    v_mov_b32_dpp v111, v110 quad_perm:[1,1,3,3] row_mask:0xf bank_mask:0xf
    v_mov_b32_dpp v115, v114 quad_perm:[1,1,3,3] row_mask:0xf bank_mask:0xf
    v_mov_b32_dpp v119, v118 quad_perm:[1,1,3,3] row_mask:0xf bank_mask:0xf
    v_mov_b32_dpp v123, v122 quad_perm:[1,1,3,3] row_mask:0xf bank_mask:0xf
    v_mov_b32_dpp v98, v98 quad_perm:[0,0,2,2] row_mask:0xf bank_mask:0xf
    v_mov_b32_dpp v102, v102 quad_perm:[0,0,2,2] row_mask:0xf bank_mask:0xf
    v_mov_b32_dpp v106, v106 quad_perm:[0,0,2,2] row_mask:0xf bank_mask:0xf
    v_mov_b32_dpp v110, v110 quad_perm:[0,0,2,2] row_mask:0xf bank_mask:0xf
    v_mov_b32_dpp v114, v114 quad_perm:[0,0,2,2] row_mask:0xf bank_mask:0xf
    v_mov_b32_dpp v118, v118 quad_perm:[0,0,2,2] row_mask:0xf bank_mask:0xf
    v_mov_b32_dpp v122, v122 quad_perm:[0,0,2,2] row_mask:0xf bank_mask:0xf
    v_max3_f32 v44, v30, v98, v102
    v_max3_f32 v44, v44, v106, v110
    v_max3_f32 v44, v44, v114, v118
    v_max_f32 v44, v44, v122
    v_sub_f32 v30, v30, v44
    v_sub_f32 v98, v98, v44
    v_sub_f32 v102, v102, v44
    v_sub_f32 v106, v106, v44
    v_sub_f32 v110, v110, v44
    v_sub_f32 v114, v114, v44
    v_sub_f32 v118, v118, v44
    v_sub_f32 v122, v122, v44
    v_mul_f32 v30, s26, v30
    v_mul_f32 v98, s26, v98
    v_mul_f32 v102, s26, v102
    v_mul_f32 v106, s26, v106
    v_mul_f32 v110, s26, v110
    v_mul_f32 v114, s26, v114
    v_mul_f32 v118, s26, v118
    v_mul_f32 v122, s26, v122
    v_exp_f32 v30, v30
    v_exp_f32 v98, v98
    v_exp_f32 v102, v102
    v_exp_f32 v106, v106
    v_exp_f32 v110, v110
    v_exp_f32 v114, v114
    v_exp_f32 v118, v118
    v_exp_f32 v122, v122
    s_nop 0
    v_mul_f32 v31, v30, v31
    v_mul_f32 v28, v30, v28
    v_mul_f32 v29, v30, v29
    v_fmac_f32 v31, v98, v99
    v_fmac_f32 v28, v98, v96
    v_fmac_f32 v29, v98, v97
    v_fmac_f32 v31, v102, v103
    v_fmac_f32 v28, v102, v100
    v_fmac_f32 v29, v102, v101
    v_fmac_f32 v31, v106, v107
    v_fmac_f32 v28, v106, v104
    v_fmac_f32 v29, v106, v105
    v_fmac_f32 v31, v110, v111
    v_fmac_f32 v28, v110, v108
    v_fmac_f32 v29, v110, v109
    v_fmac_f32 v31, v114, v115
    v_fmac_f32 v28, v114, v112
    v_fmac_f32 v29, v114, v113
    v_fmac_f32 v31, v118, v119
    v_fmac_f32 v28, v118, v116
    v_fmac_f32 v29, v118, v117
    v_fmac_f32 v31, v122, v123
    v_fmac_f32 v28, v122, v120
    v_fmac_f32 v29, v122, v121
    v_rcp_f32 v41, v31
    v_lshlrev_b32 v40, 2, v3
    v_add_u32 v40, s28, v40
    v_mul_f32 v28, v28, v41
    v_mul_f32 v29, v29, v41
    v_cvt_pk_bf16_f32 v28, v28, v29
    global_store_dword v40, v28, s[10:11]
L_fin:
L_end:
    s_endpgm
L_helper:
    s_bitcmp1_b32 s27, 2
    s_cbranch_scc1 L_probe
    s_getpc_b64 s[72:73]
L_pca:
    s_sub_u32 s72, s72, L_pca-standalone__softmax_full_bidir__decode_kernel
    s_subb_u32 s73, s73, 0
    v_lshlrev_b32 v96, 7, v3
    v_min_u32 v96, L_last-standalone__softmax_full_bidir__decode_kernel, v96
    global_load_dword v97, v96, s[72:73]
    s_cmp_lg_u32 s2, 0
    s_cbranch_scc1 L_end
    s_mov_b32 s64, 3
    s_mov_b32 s65, 0
    s_atomic_cmpswap s[64:65], s[12:13], 0x8 glc
    s_waitcnt lgkmcnt(0)
    s_cmp_lg_u32 s64, 0
    s_cbranch_scc1 L_end
    v_mul_u32_u24 v41, 4352, v3
    v_mov_b32 v47, 0
    s_mov_b32 exec_hi, 0
    global_atomic_swap v46, v41, v47, s[68:69] sc0
    global_atomic_swap v42, v41, v47, s[68:69] offset:64 sc0
    s_mov_b64 exec, -1
    s_mov_b32 s65, 0x9e3779b9
    s_atomic_add s65, s[68:69], 0x80 glc
    s_waitcnt vmcnt(0) lgkmcnt(0)
    s_add_u32 s65, s65, 0x9e3779b9
    s_mov_b32 s64, 1
    s_atomic_swap_x2 s[64:65], s[12:13], 0x8 glc
    s_waitcnt lgkmcnt(0)
    s_endpgm
L_setup:
    s_mov_b32 s64, 3
    s_mov_b32 s65, 0
    s_atomic_cmpswap s[64:65], s[12:13], 0x8 glc
    s_waitcnt lgkmcnt(0)
    s_cmp_lg_u32 s64, 0
    s_cbranch_scc1 L_setup_done
    v_mul_u32_u24 v41, 4352, v3
    v_mov_b32 v47, 0
    s_mov_b32 exec_hi, 0
    global_atomic_swap v46, v41, v47, s[68:69] sc0
    global_atomic_swap v42, v41, v47, s[68:69] offset:64 sc0
    s_mov_b64 exec, -1
    s_mov_b32 s65, 0x9e3779b9
    s_atomic_add s65, s[68:69], 0x80 glc
    s_waitcnt vmcnt(0) lgkmcnt(0)
    s_add_u32 s65, s65, 0x9e3779b9
    s_mov_b32 s64, 1
    s_atomic_swap_x2 s[64:65], s[12:13], 0x8 glc
    s_waitcnt lgkmcnt(0)
L_setup_done:
    s_load_dwordx2 s[98:99], s[12:13], 0x8 glc
    s_waitcnt lgkmcnt(0)
    s_branch L_ensure
L_probe:
    s_getreg_b32 s86, hwreg(HW_REG_XCC_ID)
    s_lshr_b32 s37, s27, 4
    s_add_u32 s37, s37, s27
    s_and_b32 s61, s37, 3
    s_and_b32 s37, s2, 7
    s_lshl_b32 s37, s37, 2
    s_and_b32 s38, s27, 3
    s_or_b32 s37, s37, s38
    s_lshr_b32 s24, s37, 3
    s_xor_b32 s24, s24, s61
    s_lshl_b32 s24, s24, 12
    s_or_b32 s24, s24, 0xc00000
    s_lshl_b32 s37, s37, 24
    s_bitcmp1_b32 s27, 3
    s_cselect_b64 s[6:7], s[8:9], s[6:7]
    s_cselect_b32 s33, 64, 0
    s_mov_b32 s32, 2
    s_sub_u32 s6, s6, s29
    s_subb_u32 s7, s7, 0
    s_add_u32 s6, s6, s37
    s_addc_u32 s7, s7, 0
    s_load_dword s36, s[6:7], s24 glc
    s_waitcnt lgkmcnt(0)
    s_memrealtime s[52:53]
L_pr:
    s_add_u32 s24, s24, 0x4200
    s_load_dword s36, s[6:7], s24 glc
    s_sub_u32 s32, s32, 1
    s_waitcnt lgkmcnt(0)
    s_cmp_lg_u32 s32, 0
    s_cbranch_scc1 L_pr
    s_memrealtime s[54:55]
    s_lshr_b32 s37, s86, 1
    s_xor_b32 s37, s37, s61
    s_and_b32 s38, s37, 1
    s_mul_i32 s38, s38, 13
    s_add_u32 s39, s33, 128
    s_waitcnt lgkmcnt(0)
    s_sub_u32 s54, s54, s52
    s_lshr_b32 s54, s54, 1
    s_min_u32 s54, s54, 128
    s_lshl_b32 s54, s54, s38
    s_bitcmp1_b32 s37, 1
    s_cselect_b32 s55, s54, 0
    s_cselect_b32 s54, 0, s54
    s_or_b32 s55, s55, 0x4000000
    s_mov_b64 s[64:65], s[54:55]
    s_atomic_add_x2 s[64:65], s[12:13], s39 glc
    s_xor_b32 s39, s39, 64
    s_mov_b64 s[56:57], 0
    s_waitcnt lgkmcnt(0)
    s_lshr_b32 s37, s65, 26
    s_cmp_lg_u32 s37, 63
    s_cbranch_scc1 L_end
    s_atomic_add_x2 s[56:57], s[12:13], s39 glc
    s_add_u32 s64, s64, s54
    s_add_u32 s65, s65, s55
    s_waitcnt lgkmcnt(0)
    s_lshr_b32 s37, s57, 26
    s_cmp_lg_u32 s37, 0
    s_cbranch_scc1 L_end
    s_cmp_eq_u32 s56, 0
    s_cbranch_scc1 L_end
    s_mov_b64 s[52:53], s[64:65]
    s_mov_b32 s64, 0x240
    s_and_b32 s72, s56, 8191
    s_bfe_u32 s73, s56, 0xd000d
    s_and_b32 s74, s57, 8191
    s_bfe_u32 s75, s57, 0xd000d
    s_add_u32 s76, s72, s73
    s_add_u32 s77, s74, s75
    s_cmp_lt_u32 s77, s76
    s_cselect_b32 s35, 2, 0
    s_sub_i32 s78, s76, s77
    s_abs_i32 s78, s78
    s_mul_i32 s78, s78, 16
    s_add_u32 s76, s76, s77
    s_cmp_lt_u32 s78, s76
    s_cbranch_scc1 L_clear
    s_and_b32 s72, s52, 8191
    s_bfe_u32 s73, s52, 0xd000d
    s_and_b32 s74, s53, 8191
    s_bfe_u32 s75, s53, 0xd000d
    s_add_u32 s76, s72, s73
    s_add_u32 s77, s74, s75
    s_cmp_lt_u32 s77, s76
    s_cselect_b32 s34, 2, 0
    s_sub_i32 s78, s76, s77
    s_abs_i32 s78, s78
    s_mul_i32 s78, s78, 16
    s_add_u32 s76, s76, s77
    s_cmp_lt_u32 s78, s76
    s_cbranch_scc1 L_clear
    s_mov_b32 s64, s34
    s_cmp_eq_u32 s35, s34
    s_cbranch_scc1 L_clear
    s_cmp_eq_u32 s33, 0
    s_cselect_b32 s64, s34, s35
    s_or_b32 s64, s64, 224
L_clear:
    s_or_b32 s64, s64, 0x100
    s_sub_u32 s37, s86, s2
    s_and_b32 s37, s37, 7
    s_lshl_b32 s37, s37, 2
    s_or_b32 s64, s64, s37
    s_mov_b32 s65, 0
    s_atomic_cmpswap s[64:65], s[12:13], 0x0 glc
    s_endpgm
L_decide:
    v_mov_b32 v41, 11272
    s_cmp_lg_u32 s30, 0
    s_cbranch_scc1 L_dec_wait
    s_load_dwordx4 s[96:99], s[12:13], 0x0
    s_mov_b32 s39, 16
    s_waitcnt lgkmcnt(0)
    s_mov_b32 s70, s96
L_dec1:
    s_cmp_lg_u32 s70, 0
    s_cbranch_scc1 L_ensure
    s_load_dword s70, s[12:13], 0x0 glc
    s_sub_u32 s39, s39, 1
    s_waitcnt lgkmcnt(0)
    s_cmp_lg_u32 s39, 0
    s_cbranch_scc1 L_dec1
    s_mov_b32 s64, 0x140
    s_mov_b32 s65, 0
    s_atomic_cmpswap s[64:65], s[12:13], 0x0 glc
    s_waitcnt lgkmcnt(0)
    s_cmp_eq_u32 s64, 0
    s_cselect_b32 s70, 0x140, s64
L_ensure:
    s_cmp_lg_u32 s98, 1
    s_cbranch_scc1 L_setup
    v_mov_b32 v41, 11272
    v_mov_b32 v48, s99
    v_mov_b32 v53, s70
    ds_write2_b32 v41, v48, v53 offset0:0 offset1:1
    s_waitcnt lgkmcnt(0)
L_dec_wait:
    s_barrier
    ds_read_b32 v53, v41 offset:4
    s_waitcnt lgkmcnt(0)
    v_readfirstlane_b32 s70, v53
    s_nop 1
    s_lshr_b32 s37, s70, 2
    s_add_u32 s37, s37, s2
    s_bfe_u32 s38, s37, 0x20001
    s_xor_b32 s38, s38, s70
    s_and_b32 s38, s38, 3
    s_and_b32 s37, s37, 1
    s_lshl_b32 s37, s37, 2
    s_or_b32 s83, s37, s38
    s_and_b32 s38, s38, 2
    s_lshl_b32 s50, s38, 3
    s_bfe_u32 s82, s70, 0x10006
    s_cmp_eq_u32 s82, 0
    s_cselect_b32 s62, 55, 50
    s_cselect_b32 s48, 60, 60
    s_cselect_b32 s50, s50, 0
    s_cselect_b32 s52, 64, 0
    s_bitcmp1_b32 s70, 5
    s_cselect_b32 s62, 54, s62
    s_cselect_b32 s48, 60, s48
    s_cselect_b32 s52, 54, s52
    s_cselect_b32 s49, 7, 0
    s_cselect_b32 s53, 2, 0
    s_lshl_b32 s48, s48, 3
    s_branch L_k_on
L_export:
    s_sub_u32 s37, 0, s27
    s_and_b32 s37, s37, 7
    v_and_b32 v61, 56, v3
    v_add_u32 v61, s37, v61
    v_and_b32 v60, 7, v3
    v_lshlrev_b32 v60, 4, v60
    v_lshl_add_u32 v60, v61, 7, v60
    v_add_u32 v60, s71, v60
    v_mov_b32 v41, 11272
    ds_read_b128 v[96:99], v60
    ds_read_b32 v104, v41
    s_lshl_b32 s37, s27, 3
    s_or_b32 s37, s37, s83
    s_lshl_b32 s37, s37, 2
    s_or_b32 s37, s37, s30
    s_lshl_b32 s37, s37, 10
    s_add_u32 s37, s37, 0x200000
    v_lshl_add_u32 v47, v3, 4, s37
    s_mov_b32 s37, 0xff
    s_waitcnt lgkmcnt(0)
    v_lshrrev_b32 v105, 8, v104
    v_lshrrev_b32 v106, 16, v104
    v_lshrrev_b32 v107, 24, v104
    v_bfi_b32 v96, s37, v104, v96
    v_bfi_b32 v97, s37, v105, v97
    v_bfi_b32 v98, s37, v106, v98
    v_bfi_b32 v99, s37, v107, v99
    global_store_dwordx4 v47, v[96:99], s[68:69] sc1
    s_mov_b32 s60, 64
    s_branch L_exported
L_import2:
    s_sub_u32 s60, s60, 1
    s_cbranch_scc1 L_redo
    s_lshl_b32 s37, s27, 3
    s_or_b32 s37, s37, s83
    s_lshl_b32 s37, s37, 2
    s_or_b32 s37, s37, s30
    s_lshl_b32 s37, s37, 10
    s_add_u32 s37, s37, 0x200000
    v_lshl_add_u32 v47, v3, 4, s37
    global_load_dwordx4 v[100:103], v47, s[68:69] sc1
    s_waitcnt vmcnt(0)
L_import:
    s_cmp_eq_u32 s53, 0
    s_cbranch_scc1 L_v_on
    s_waitcnt vmcnt(8)
    v_xor_b32 v96, v100, v104
    v_xor_b32 v97, v101, v105
    v_xor_b32 v98, v102, v106
    v_xor_b32 v99, v103, v107
    v_or3_b32 v96, v96, v97, v98
    v_or_b32 v96, v96, v99
    v_and_b32 v96, 0xff, v96
    v_cmp_ne_u32 vcc, 0, v96
    s_cbranch_vccnz L_import2
    v_max3_f32 v96, v100, v101, v102
    v_max_f32 v96, v96, v103
    v_lshrrev_b32 v97, 4, v61
    s_lshl_b32 s37, s30, 2
    v_lshl_add_u32 v97, v97, 8, s37
    v_subrev_u32 v98, 9, v61
    v_cmp_gt_u32 vcc, 45, v98
    s_and_saveexec_b64 s[54:55], vcc
    ds_write_b128 v60, v[100:103]
    ds_max_f32 v97, v96 offset:10240
    ds_max_f32 v97, v96 offset:10304
    ds_max_f32 v97, v96 offset:10368
    ds_max_f32 v97, v96 offset:10432
    s_mov_b64 exec, -1
L_imported:
    ds_read_b32 v46, v52 offset:10240
    s_waitcnt lgkmcnt(0)
    v_sub_f32 v47, v43, v46
    v_mul_f32 v47, s26, v47
    v_exp_f32 v47, v47
    v_mov_b32 v43, v46
    v_mul_f32 v44, s26, v46
    v_mul_f32 v45, v45, v47
    v_mul_f32 v28, v28, v47
    v_mul_f32 v29, v29, v47
    v_mul_f32 v30, v30, v47
    v_mul_f32 v31, v31, v47
    s_branch L_v_on
L_t_claim:
    s_lshl_b32 s37, s84, 2
    s_lshl_b32 s33, 1, s37
    s_atomic_add s33, s[66:67], 0x0 glc
    s_branch L_round
L_ticket:
    s_cmp_ge_u32 s34, 0x400
    s_cbranch_scc1 L_round
L_t_got:
    s_waitcnt lgkmcnt(0)
    s_lshl_b32 s37, s84, 2
    s_lshr_b32 s38, s33, s37
    s_and_b32 s38, s38, 255
    s_cmp_ge_u32 s38, s85
    s_cbranch_scc1 L_t_dry
    s_lshr_b32 s34, s38, 2
    s_lshl_b32 s34, s34, 3
    s_and_b32 s37, s38, 3
    s_or_b32 s34, s34, s37
    s_lshl_b32 s37, s84, 1
    s_or_b32 s34, s34, s37
    s_add_u32 s37, s62, 1
    s_lshl_b32 s37, s37, 4
    s_add_u32 s34, s34, s37
    v_mov_b32 v48, s34
    ds_write_b32 v49, v48
    s_waitcnt lgkmcnt(0)
    s_branch L_t_claim
L_t_dry:
    s_xor_b32 s84, s84, 2
    s_lshl_b32 s37, s84, 2
    s_lshr_b32 s38, s33, s37
    s_and_b32 s38, s38, 255
    s_cmp_lt_u32 s38, s85
    s_cbranch_scc1 L_t_other
    s_mov_b32 s33, 0x10000000
    s_atomic_add s33, s[66:67], 0x0 glc
    s_waitcnt lgkmcnt(0)
    s_lshr_b32 s34, s33, 28
    s_or_b32 s34, s34, 8192
    v_mov_b32 v48, s34
    ds_write_b32 v49, v48
    s_waitcnt lgkmcnt(0)
    s_branch L_round
L_t_other:
    s_lshl_b32 s33, 1, s37
    s_atomic_add s33, s[66:67], 0x0 glc
    s_branch L_t_got
L_slow:
    s_nop 1
    v_max_f32_dpp v46, v40, v40 row_ror:4 row_mask:0xf bank_mask:0xf
    s_nop 1
    v_max_f32_dpp v46, v46, v46 row_ror:8 row_mask:0xf bank_mask:0xf
    s_nop 0
    v_readlane_b32 s56, v46, 0
    v_readlane_b32 s57, v46, 16
    v_readlane_b32 s58, v46, 32
    v_readlane_b32 s59, v46, 48
    s_nop 1
    v_max_f32 v46, s56, v43
    v_max_f32 v46, s57, v46
    v_max_f32 v46, s58, v46
    v_max_f32 v46, s59, v46
    v_sub_f32 v47, v43, v46
    v_mul_f32 v47, s26, v47
    v_exp_f32 v47, v47
    v_mov_b32 v43, v46
    v_mul_f32 v44, s26, v46
    v_mul_f32 v45, v45, v47
    v_mul_f32 v28, v28, v47
    v_mul_f32 v29, v29, v47
    v_mul_f32 v30, v30, v47
    v_mul_f32 v31, v31, v47
L_last:
    s_branch L_back
L_redo:
    s_mov_b64 s[72:73], s[6:7]
    s_mov_b32 s74, 16777216
    s_mov_b32 s75, 0x20000
    s_sub_u32 s54, 0, s27
    s_and_b32 s54, s54, 7
L_redo1:
    s_cmp_lt_u32 s54, 9
    s_cbranch_scc1 L_redo2
    s_lshr_b32 s55, s54, 4
    s_cmp_ge_u32 s54, 54
    s_cselect_b32 s55, 3, s55
    s_lshl_b32 s55, s55, 8
    v_add_u32 v47, s55, v50
    ds_read_b128 v[24:27], v47 offset:8192
    s_waitcnt lgkmcnt(0)
    v_bfe_u32 v46, v3, 2, 2
    v_cmp_eq_u32 vcc, 0, v46
    s_nop 1
    v_cndmask_b32 v4, 0, v24, vcc
    v_cndmask_b32 v5, 0, v25, vcc
    v_cndmask_b32 v6, 0, v26, vcc
    v_cndmask_b32 v7, 0, v27, vcc
    v_cmp_eq_u32 vcc, 1, v46
    s_nop 1
    v_cndmask_b32 v8, 0, v24, vcc
    v_cndmask_b32 v9, 0, v25, vcc
    v_cndmask_b32 v10, 0, v26, vcc
    v_cndmask_b32 v11, 0, v27, vcc
    v_cmp_eq_u32 vcc, 2, v46
    s_nop 1
    v_cndmask_b32 v12, 0, v24, vcc
    v_cndmask_b32 v13, 0, v25, vcc
    v_cndmask_b32 v14, 0, v26, vcc
    v_cndmask_b32 v15, 0, v27, vcc
    v_cmp_eq_u32 vcc, 3, v46
    s_nop 1
    v_cndmask_b32 v16, 0, v24, vcc
    v_cndmask_b32 v17, 0, v25, vcc
    v_cndmask_b32 v18, 0, v26, vcc
    v_cndmask_b32 v19, 0, v27, vcc
    s_cmp_ge_u32 s54, 54
    s_cbranch_scc1 L_imported
    s_add_u32 s37, s54, s27
    s_and_b32 s37, s37, s49
    s_cselect_b32 s37, 0, s54
    s_cmp_ge_u32 s54, s52
    s_cselect_b32 s37, 0, s37
    s_cmp_lt_u32 s37, 9
    s_cselect_b32 s51, s92, s93
    s_cselect_b32 s100, s93, s92
    s_cselect_b32 s61, s95, s83
    s_add_u32 s101, s100, 65536
    s_lshr_b32 s24, s54, 2
    s_xor_b32 s37, s24, s61
    s_xor_b32 s37, s37, s63
    s_lshl_b32 s24, s24, 20
    s_bfe_u32 s38, s54, 65536
    s_lshl_b32 s38, s38, 9
    s_bfe_u32 s39, s54, 65537
    s_lshl_b32 s39, s39, 17
    s_or_b32 s38, s38, s39
    s_or_b32 s24, s24, s38
    s_bitcmp1_b32 s37, 0
    s_cselect_b32 s38, 524288, 0
    s_or_b32 s24, s24, s38
    s_bitcmp1_b32 s37, 1
    s_cselect_b32 s38, s51, 0
    s_or_b32 s24, s24, s38
    s_bitcmp1_b32 s37, 2
    s_cselect_b32 s38, 262144, 0
    s_or_b32 s24, s24, s38
    s_add_u32 s3, s24, 16384
    buffer_load_dwordx4 v[128:131], v1, s[72:75], s24 offen nt
    s_add_u32 s89, s24, 65536
    buffer_load_dwordx4 v[132:135], v1, s[72:75], s89 offen nt
    s_add_u32 s90, s24, s100
    buffer_load_dwordx4 v[136:139], v1, s[72:75], s90 offen nt
    s_add_u32 s91, s24, s101
    buffer_load_dwordx4 v[140:143], v1, s[72:75], s91 offen nt
    buffer_load_dwordx4 v[144:147], v1, s[72:75], s3 offen nt
    s_add_u32 s89, s3, 65536
    buffer_load_dwordx4 v[148:151], v1, s[72:75], s89 offen nt
    s_add_u32 s90, s3, s100
    buffer_load_dwordx4 v[152:155], v1, s[72:75], s90 offen nt
    s_add_u32 s91, s3, s101
    buffer_load_dwordx4 v[156:159], v1, s[72:75], s91 offen nt
    s_lshl_b32 s37, s54, 7
    s_add_u32 s37, s37, s71
    v_and_b32 v96, 60, v3
    v_add_u32 v96, s37, v96
    s_lshl_b32 s37, s30, 2
    s_add_u32 s37, s37, s55
    v_mov_b32 v97, s37
    s_waitcnt vmcnt(0)
    v_mfma_f32_16x16x32_bf16 v[24:27], v[128:131], v[4:7], 0
    v_mfma_f32_16x16x32_bf16 v[24:27], v[132:135], v[8:11], v[24:27]
    v_mfma_f32_16x16x32_bf16 v[24:27], v[136:139], v[12:15], v[24:27]
    v_mfma_f32_16x16x32_bf16 v[24:27], v[140:143], v[16:19], v[24:27]
    s_nop 7
    v_mov_b32_dpp v41, v24 quad_perm:[0,0,0,0] row_mask:0xf bank_mask:0xf
    v_mov_b32_dpp v46, v26 quad_perm:[2,2,2,2] row_mask:0xf bank_mask:0xf
    s_nop 0
    v_add_f32_dpp v41, v25, v41 quad_perm:[1,1,1,1] row_mask:0xf bank_mask:0xf
    v_add_f32_dpp v46, v27, v46 quad_perm:[3,3,3,3] row_mask:0xf bank_mask:0xf
    v_add_f32 v41, v41, v46
    ds_write_b32 v96, v41 offset:0
    ds_max_f32 v97, v41 offset:10240
    ds_max_f32 v97, v41 offset:10304
    ds_max_f32 v97, v41 offset:10368
    ds_max_f32 v97, v41 offset:10432
    s_waitcnt lgkmcnt(0)
    v_mfma_f32_16x16x32_bf16 v[24:27], v[144:147], v[4:7], 0
    v_mfma_f32_16x16x32_bf16 v[24:27], v[148:151], v[8:11], v[24:27]
    v_mfma_f32_16x16x32_bf16 v[24:27], v[152:155], v[12:15], v[24:27]
    v_mfma_f32_16x16x32_bf16 v[24:27], v[156:159], v[16:19], v[24:27]
    s_nop 7
    v_mov_b32_dpp v41, v24 quad_perm:[0,0,0,0] row_mask:0xf bank_mask:0xf
    v_mov_b32_dpp v46, v26 quad_perm:[2,2,2,2] row_mask:0xf bank_mask:0xf
    s_nop 0
    v_add_f32_dpp v41, v25, v41 quad_perm:[1,1,1,1] row_mask:0xf bank_mask:0xf
    v_add_f32_dpp v46, v27, v46 quad_perm:[3,3,3,3] row_mask:0xf bank_mask:0xf
    v_add_f32 v41, v41, v46
    ds_write_b32 v96, v41 offset:64
    ds_max_f32 v97, v41 offset:10240
    ds_max_f32 v97, v41 offset:10304
    ds_max_f32 v97, v41 offset:10368
    ds_max_f32 v97, v41 offset:10432
    s_waitcnt lgkmcnt(0)
L_redo2:
    s_add_u32 s54, s54, 8
    s_branch L_redo1
.section .rodata,"a"
.p2align 6
.amdhsa_kernel standalone__softmax_full_bidir__decode_kernel
  .amdhsa_next_free_vgpr 160
  .amdhsa_next_free_sgpr 102
  .amdhsa_accum_offset 160
  .amdhsa_group_segment_fixed_size 0
  .amdhsa_kernarg_size 48
  .amdhsa_user_sgpr_count 2
  .amdhsa_user_sgpr_kernarg_segment_ptr 1
  .amdhsa_system_sgpr_workgroup_id_x 1
.end_amdhsa_kernel
```
